```python
import torch

def _softmax(x, axis=-1):
    return torch.softmax(x, dim=axis)
def _gelu(x):
    return torch.nn.functional.gelu(x, approximate="tanh")
def _silu(x):
    return torch.nn.functional.silu(x)
def _sigmoid(x):
    return torch.sigmoid(x)
def _layernorm(x, axis=-1, eps=1e-5):
    m = x.mean(dim=axis, keepdim=True)
    v = x.var(dim=axis, keepdim=True, unbiased=False)
    return (x - m) / torch.sqrt(v + eps)
def _scatter_add(tgt, idx, src, axis=0):
    return tgt.clone().index_add_(axis, idx, src)
def _segment_sum(src, seg, n):
    out = torch.zeros((n,) + src.shape[1:], dtype=src.dtype)
    return out.index_add_(0, seg, src)
def _pad(x, pw):
    flat = tuple(v for pair in reversed(pw) for v in pair)
    return torch.nn.functional.pad(x, flat)

kernel_name = 'standalone__fused_io_aware_attn__prompt'

def setup_inputs():

    _w = (lambda a: (lambda t: t.to(torch.bfloat16) if t.is_floating_point() else t)(torch.as_tensor(a)))
    B, H, S = 2, 32, 2048
    Dh = max(1, 640 // 32)
    return {
        "q": _w((lambda *s: torch.randn(*s, dtype=torch.bfloat16) * 0.8)(B, H, S, Dh)),
        "k": _w((lambda *s: torch.randn(*s, dtype=torch.bfloat16) * 0.8)(B, H, S, Dh)),
        "v": _w((lambda *s: torch.randn(*s, dtype=torch.bfloat16) * 0.05)(B, H, S, Dh)),
    }

def reference(q, k, v):
    scale = q.shape[-1] ** -0.5
    s = torch.einsum('bhqd,bhkd->bhqk', q, k) * scale
    p = _softmax(s, axis=-1)
    return torch.einsum('bhqk,bhkd->bhqd', p, v)
```

```asm
; @launch grid=(256,1,1) block=(512,1,1) lds=163840
.amdgcn_target "amdgcn-amd-amdhsa--gfx950"
.text
.globl standalone__fused_io_aware_attn__prompt_kernel
.p2align 8
.type standalone__fused_io_aware_attn__prompt_kernel,@function
standalone__fused_io_aware_attn__prompt_kernel:
    s_cmp_ge_u32 s2, 256
    s_cbranch_scc1 L_end
    s_load_dwordx2 s[12:13], s[0:1], 0
    s_load_dwordx2 s[16:17], s[0:1], 8
    s_load_dwordx2 s[20:21], s[0:1], 16
    v_lshrrev_b32 v1, 6, v0
    v_and_b32 v2, 63, v0
    v_readfirstlane_b32 s32, v1
    s_and_b32 s42, s2, 7
    s_lshl_b32 s42, s42, 3
    s_lshr_b32 s43, s2, 5
    s_add_u32 s42, s42, s43
    s_mul_i32 s33, s42, 81920
    s_bfe_u32 s35, s2, 0x20003
    s_mulk_i32 s35, 20480
    s_add_u32 s35, s35, s33
    v_lshlrev_b32 v173, 4, v2
    v_lshlrev_b32 v174, 2, v2
    s_lshr_b32 s74, s32, 1
    s_and_b32 s44, s32, 1
    s_mulk_i32 s74, 640
    s_lshl_b32 s34, s74, 3
    s_mul_i32 s36, s44, 1280
    s_add_u32 s36, s36, s34
    s_add_u32 s35, s35, s36
    s_mul_i32 s37, s44, 40960
    s_add_u32 s37, s37, s33
    s_add_u32 s38, s37, s74
    s_mul_i32 s83, s44, 38912
    s_add_u32 s83, s83, 43008
    s_add_u32 m0, s83, s74
    s_mov_b32 s14, 5242880
    s_mov_b32 s15, 0x20000
    s_mov_b64 s[18:19], s[14:15]
    s_mov_b64 s[22:23], s[14:15]
    s_mul_i32 s82, s44, 118784
    s_addk_i32 s82, 4096
    s_waitcnt lgkmcnt(0)
    buffer_load_dwordx4 v[136:139], v173, s[12:15], s35 offen
    buffer_load_dword v140, v174, s[12:15], s35 offen offset:1024
    s_mov_b32 exec_hi, 0xff
    buffer_load_dwordx4 v173, s[16:19], s38 offen lds
    s_add_u32 m0, s82, s74
    s_barrier
    buffer_load_dwordx4 v173, s[20:23], s38 offen lds
    s_mov_b32 exec_hi, -1
    buffer_load_dwordx4 v[186:189], v173, s[12:15], s35 offen offset:2560
    buffer_load_dword v190, v174, s[12:15], s35 offen offset:3584
    s_load_dwordx2 s[24:25], s[0:1], 24
    s_lshl_b32 s45, s32, 8
    s_and_b32 s45, s45, 1024
    s_add_u32 s37, s37, s45
    s_bitcmp1_b32 s32, 1
    s_cselect_b32 s42, s82, s83
    s_cselect_b64 s[28:29], s[20:21], s[16:17]
    s_add_u32 m0, s42, s45
    s_mov_b64 s[30:31], s[14:15]
    s_mov_b64 s[26:27], s[14:15]
    s_mov_b32 s72, 0x3ea52b5c
    s_mov_b32 s73, s72
    s_mov_b32 s39, 0xffff0000
    v_mov_b32 v4, 0
    v_mov_b32 v5, 0
    v_and_b32 v3, 31, v0
    v_bfe_u32 v6, v0, 5, 1
    v_mfma_f32_32x32x4_2b_bf16 v[8:39], v[4:5], v[4:5], 0
    v_mfma_f32_32x32x4_2b_bf16 v[40:71], v[4:5], v[4:5], 0
    v_and_b32 v1, 1, v0
    v_subrev_u32 v1, 1, v1
    v_and_b32 v4, 0x3f80, v1
    v_lshlrev_b32 v1, 3, v0
    v_mul_u32_u24 v3, 40, v3
    ds_write_b64 v1, v[4:5]
    v_lshl_add_u32 v172, v6, 4, v3
    v_add_u32 v169, s83, v172
    s_add_u32 s42, s36, 143360
    v_add_u32 v179, s42, v173
    v_add_u32 v180, s42, v174
    v_add_u32 v176, s42, v172
    s_sub_u32 s45, s36, s34
    s_sub_u32 s42, s42, s45
    s_lshl_b32 s43, s44, 5
    v_xor_b32 v178, s43, v2
    v_mad_u32_u24 v178, v178, 40, s42
    s_sub_u32 s42, s42, s45
    s_addk_i32 s42, 1280
    v_add_u32 v177, s42, v172
    v_bfe_u32 v1, v0, 2, 2
    v_lshl_add_u32 v1, v6, 3, v1
    v_mad_u32_u24 v1, v1, 40, s82
    v_and_b32 v2, 19, v0
    v_and_b32 v5, 3, v0
    v_lshl_add_u32 v1, v2, 1, v1
    v_mad_u32_u24 v1, v5, 6, v1
    v_lshlrev_b32 v6, 6, v6
    v_and_b32 v5, 2, v0
    v_lshl_add_u32 v6, v5, 2, v6
    v_cmp_lt_u32 vcc, 16, v2
    v_add_u32 v6, 160, v6
    s_movk_i32 s41, 3840
    v_cndmask_b32 v170, v1, v6, vcc
    v_cndmask_b32 v171, 1, 0, vcc
    s_waitcnt vmcnt(5)
    v_lshlrev_b32 v2, 16, v136
    v_lshlrev_b32 v4, 16, v137
    v_and_b32 v3, s39, v136
    v_and_b32 v5, s39, v137
    v_pk_mul_f32 v[2:3], v[2:3], s[72:73]
    v_pk_mul_f32 v[4:5], v[4:5], s[72:73]
    v_cvt_pk_bf16_f32 v136, v2, v3
    v_cvt_pk_bf16_f32 v137, v4, v5
    v_lshlrev_b32 v2, 16, v138
    v_lshlrev_b32 v4, 16, v139
    v_and_b32 v3, s39, v138
    v_and_b32 v5, s39, v139
    v_pk_mul_f32 v[2:3], v[2:3], s[72:73]
    v_pk_mul_f32 v[4:5], v[4:5], s[72:73]
    v_cvt_pk_bf16_f32 v138, v2, v3
    v_cvt_pk_bf16_f32 v139, v4, v5
    ds_write_b128 v179, v[136:139] offset:0
    s_waitcnt vmcnt(4)
    v_lshlrev_b32 v2, 16, v140
    v_and_b32 v3, s39, v140
    v_pk_mul_f32 v[2:3], v[2:3], s[72:73]
    v_cvt_pk_bf16_f32 v140, v2, v3
    ds_write_b32 v180, v140 offset:1024
    s_waitcnt lgkmcnt(0)
    s_waitcnt vmcnt(3)
    s_barrier
    ds_read_b64 a[16:17], v178 offset:32
    ds_read_b64 a[24:25], v169 offset:32
    ds_read_b64 a[20:21], v169 offset:0
    ds_read_b64 a[22:23], v169 offset:8
    ds_read_b64 a[0:1], v176 offset:0
    ds_read_b64 a[2:3], v176 offset:8
    s_waitcnt lgkmcnt(4)
    v_mfma_f32_32x32x4_2b_bf16 v[72:103], a[24:25], a[16:17], 4.0 cbsz:1 abid:0
    ds_read_b64 a[4:5], v177 offset:0
    ds_read_b64 a[6:7], v177 offset:8
    ds_read_b64 a[30:31], v169 offset:1312
    ds_read_b64 a[26:27], v169 offset:1280
    ds_read_b64 a[28:29], v169 offset:1288
    buffer_load_dwordx4 v173, s[28:31], s37 offen offset:2048 lds
    s_lshr_b32 s42, s32, 1
    s_mul_i32 s42, s42, 38912
    s_mul_i32 s45, s44, 6144
    s_sub_u32 s43, s42, s45
    s_add_u32 s42, s42, s45
    s_addk_i32 s42, 6144
    s_addk_i32 s43, 12288
    v_add_u32 v175, s42, v173
    v_add_u32 v181, s43, v173
    v_mad_u32_u24 v183, v174, 10, s43
    v_lshrrev_b32 v1, 4, v174
    s_waitcnt lgkmcnt(5)
    v_mfma_f32_32x32x16_bf16 v[72:87], a[20:23], a[0:3], v[72:87]
    s_waitcnt lgkmcnt(3)
    v_mfma_f32_32x32x16_bf16 v[88:103], a[20:23], a[4:7], v[88:103]
    v_and_b32 v1, 8, v1
    v_sub_u32 v1, v172, v1
    v_add_u32 v182, s43, v1
    v_and_b32 v1, 0x100, v173
    v_mad_u32_u24 v185, v1, 9, v173
    v_mad_u32_u24 v184, v1, 11, v181
    v_mov_b32 v168, 0xdddd
    s_mov_b64 s[46:47], -1
    s_setprio 3
    s_add_u32 m0, m0, 4096
    s_add_u32 s37, s37, 4096
    buffer_load_dwordx4 v173, s[28:31], s37 offen lds
    s_waitcnt lgkmcnt(2)
    v_mfma_f32_32x32x4_2b_bf16 v[104:135], a[30:31], a[16:17], 4.0 cbsz:1 abid:0
    v_exp_f32 v72, v72
    v_exp_f32 v73, v73
    v_exp_f32 v74, v74
    v_exp_f32 v75, v75
    v_exp_f32 v76, v76
    v_exp_f32 v77, v77
    v_exp_f32 v78, v78
    v_exp_f32 v79, v79
    v_exp_f32 v80, v80
    v_exp_f32 v81, v81
    v_exp_f32 v82, v82
    v_exp_f32 v83, v83
    v_exp_f32 v84, v84
    v_exp_f32 v85, v85
    v_exp_f32 v86, v86
    v_exp_f32 v87, v87
    s_nop 1
    s_waitcnt lgkmcnt(0)
    v_mfma_f32_32x32x16_bf16 v[104:119], a[26:29], a[0:3], v[104:119]
    buffer_load_dwordx4 v173, s[28:31], s37 offen offset:2048 lds
    v_exp_f32 v88, v88
    v_exp_f32 v89, v89
    v_exp_f32 v90, v90
    v_exp_f32 v91, v91
    v_mfma_f32_32x32x16_bf16 v[120:135], a[26:29], a[4:7], v[120:135]
    v_exp_f32 v92, v92
    v_exp_f32 v93, v93
    v_exp_f32 v94, v94
    v_exp_f32 v95, v95
    v_exp_f32 v96, v96
    v_exp_f32 v97, v97
    v_exp_f32 v98, v98
    v_exp_f32 v99, v99
    v_exp_f32 v100, v100
    v_exp_f32 v101, v101
    v_exp_f32 v102, v102
    v_exp_f32 v103, v103
    s_waitcnt vmcnt(4)
    v_lshlrev_b32 v2, 16, v186
    v_lshlrev_b32 v4, 16, v187
    v_and_b32 v3, s39, v186
    v_and_b32 v5, s39, v187
    v_pk_mul_f32 v[2:3], v[2:3], s[72:73]
    v_pk_mul_f32 v[4:5], v[4:5], s[72:73]
    v_cvt_pk_bf16_f32 v186, v2, v3
    v_cvt_pk_bf16_f32 v187, v4, v5
    v_lshlrev_b32 v2, 16, v188
    v_lshlrev_b32 v4, 16, v189
    v_and_b32 v3, s39, v188
    v_and_b32 v5, s39, v189
    v_pk_mul_f32 v[2:3], v[2:3], s[72:73]
    v_pk_mul_f32 v[4:5], v[4:5], s[72:73]
    v_cvt_pk_bf16_f32 v188, v2, v3
    v_cvt_pk_bf16_f32 v189, v4, v5
    ds_write_b128 v179, v[186:189] offset:2560
    s_waitcnt vmcnt(3)
    v_lshlrev_b32 v2, 16, v190
    v_and_b32 v3, s39, v190
    v_pk_mul_f32 v[2:3], v[2:3], s[72:73]
    v_cvt_pk_bf16_f32 v190, v2, v3
    ds_write_b32 v180, v190 offset:3584
    s_waitcnt lgkmcnt(0)
    s_waitcnt vmcnt(5)
    s_barrier
    ds_read_b64 a[18:19], v178 offset:2592
    ds_read_b64_tr_b16 a[32:33], v170 offset:0
    ds_read_b64_tr_b16 a[34:35], v170 offset:160
    s_setprio 2
    s_add_u32 m0, m0, 4096
    s_add_u32 s37, s37, 4096
    buffer_load_dwordx4 v173, s[28:31], s37 offen lds
    v_exp_f32 v104, v104
    v_exp_f32 v105, v105
    ds_read_b64_tr_b16 a[36:37], v170 offset:640
    ds_read_b64_tr_b16 a[38:39], v170 offset:800
    v_exp_f32 v106, v106
    v_exp_f32 v107, v107
    ds_read_b64 a[8:9], v176 offset:2560
    ds_read_b64 a[10:11], v176 offset:2568
    v_exp_f32 v108, v108
    v_exp_f32 v109, v109
    s_waitcnt lgkmcnt(6)
    v_mfma_f32_32x32x4_2b_bf16 v[136:167], a[24:25], a[18:19], 4.0 cbsz:1 abid:0
    ds_read_b64 a[12:13], v177 offset:2560
    ds_read_b64 a[14:15], v177 offset:2568
    v_exp_f32 v110, v110
    v_exp_f32 v111, v111
    v_exp_f32 v112, v112
    v_exp_f32 v113, v113
    s_waitcnt lgkmcnt(6)
    v_smfmac_f32_32x32x32_bf16 v[8:23], a[32:35], v[72:79], v168
    v_exp_f32 v114, v114
    v_exp_f32 v115, v115
    v_exp_f32 v116, v116
    v_exp_f32 v117, v117
    v_smfmac_f32_32x32x32_bf16 v[40:55], a[32:35], v[88:95], v168
    ds_read_b64_tr_b16 a[40:41], v170 offset:1280
    ds_read_b64_tr_b16 a[42:43], v170 offset:1440
    v_exp_f32 v118, v118
    v_exp_f32 v119, v119
    v_exp_f32 v120, v120
    v_exp_f32 v121, v121
    s_waitcnt lgkmcnt(6)
    v_smfmac_f32_32x32x32_bf16 v[8:23], a[36:39], v[80:87], v168
    buffer_load_dwordx4 v173, s[28:31], s37 offen offset:2048 lds
    v_exp_f32 v122, v122
    v_exp_f32 v123, v123
    v_exp_f32 v124, v124
    v_exp_f32 v125, v125
    s_waitcnt lgkmcnt(4)
    v_mfma_f32_32x32x16_bf16 v[136:151], a[20:23], a[8:11], v[136:151]
    ds_read_b64_tr_b16 a[44:45], v170 offset:1920
    ds_read_b64_tr_b16 a[46:47], v170 offset:2080
    v_exp_f32 v126, v126
    v_exp_f32 v127, v127
    v_exp_f32 v128, v128
    s_waitcnt lgkmcnt(4)
    v_mfma_f32_32x32x16_bf16 v[152:167], a[20:23], a[12:15], v[152:167]
    v_exp_f32 v129, v129
    v_exp_f32 v130, v130
    v_exp_f32 v131, v131
    v_smfmac_f32_32x32x32_bf16 v[40:55], a[36:39], v[96:103], v168
    v_exp_f32 v132, v132
    v_exp_f32 v133, v133
    v_exp_f32 v134, v134
    v_exp_f32 v135, v135
    s_setprio 2
    s_waitcnt vmcnt(2)
    s_barrier
    s_add_u32 m0, m0, 4096
    s_add_u32 s37, s37, 4096
    buffer_load_dwordx4 v173, s[28:31], s37 offen lds
    v_mfma_f32_32x32x4_2b_bf16 v[72:103], a[30:31], a[18:19], 4.0 cbsz:1 abid:0
    ds_read_b64 a[24:25], v169 offset:2592
    v_exp_f32 v136, v136
    v_exp_f32 v137, v137
    v_exp_f32 v138, v138
    v_exp_f32 v139, v139
    v_exp_f32 v140, v140
    v_exp_f32 v141, v141
    v_exp_f32 v142, v142
    v_exp_f32 v143, v143
    s_waitcnt lgkmcnt(3)
    v_smfmac_f32_32x32x32_bf16 v[8:23], a[40:43], v[104:111], v168
    ds_read_b64 a[20:21], v169 offset:2560
    ds_read_b64 a[22:23], v169 offset:2568
    v_exp_f32 v144, v144
    v_exp_f32 v145, v145
    v_exp_f32 v146, v146
    v_exp_f32 v147, v147
    v_smfmac_f32_32x32x32_bf16 v[40:55], a[40:43], v[120:127], v168
    v_exp_f32 v148, v148
    v_exp_f32 v149, v149
    v_exp_f32 v150, v150
    v_exp_f32 v151, v151
    v_mfma_f32_32x32x16_bf16 v[72:87], a[26:29], a[8:11], v[72:87]
    buffer_load_dwordx4 v173, s[28:31], s37 offen offset:2048 lds
    v_exp_f32 v152, v152
    v_exp_f32 v153, v153
    v_exp_f32 v154, v154
    v_exp_f32 v155, v155
    v_mfma_f32_32x32x16_bf16 v[88:103], a[26:29], a[12:15], v[88:103]
    v_exp_f32 v156, v156
    v_exp_f32 v157, v157
    v_exp_f32 v158, v158
    v_exp_f32 v159, v159
    s_waitcnt lgkmcnt(3)
    v_smfmac_f32_32x32x32_bf16 v[8:23], a[44:47], v[112:119], v168
    v_exp_f32 v160, v160
    v_exp_f32 v161, v161
    v_exp_f32 v162, v162
    v_exp_f32 v163, v163
    v_smfmac_f32_32x32x32_bf16 v[40:55], a[44:47], v[128:135], v168
    v_exp_f32 v164, v164
    v_exp_f32 v165, v165
    v_exp_f32 v166, v166
    v_exp_f32 v167, v167
    s_setprio 1
    s_add_u32 m0, m0, 4096
    s_add_u32 s37, s37, 4096
    buffer_load_dwordx4 v173, s[28:31], s37 offen lds
    s_waitcnt lgkmcnt(2)
    v_mfma_f32_32x32x4_2b_bf16 v[104:135], a[24:25], a[16:17], 4.0 cbsz:1 abid:0
    v_exp_f32 v72, v72
    v_exp_f32 v73, v73
    v_exp_f32 v74, v74
    v_exp_f32 v75, v75
    v_exp_f32 v76, v76
    v_exp_f32 v77, v77
    v_exp_f32 v78, v78
    v_exp_f32 v79, v79
    v_smfmac_f32_32x32x32_bf16 v[24:39], a[32:35], v[136:143], v168
    v_exp_f32 v80, v80
    v_exp_f32 v81, v81
    v_exp_f32 v82, v82
    v_exp_f32 v83, v83
    v_smfmac_f32_32x32x32_bf16 v[56:71], a[32:35], v[152:159], v168
    v_exp_f32 v84, v84
    v_exp_f32 v85, v85
    v_exp_f32 v86, v86
    v_exp_f32 v87, v87
    s_waitcnt lgkmcnt(0)
    v_mfma_f32_32x32x16_bf16 v[104:119], a[20:23], a[0:3], v[104:119]
    buffer_load_dwordx4 v173, s[28:31], s37 offen offset:2048 lds
    v_exp_f32 v88, v88
    v_exp_f32 v89, v89
    v_exp_f32 v90, v90
    v_exp_f32 v91, v91
    v_mfma_f32_32x32x16_bf16 v[120:135], a[20:23], a[4:7], v[120:135]
    v_exp_f32 v92, v92
    v_exp_f32 v93, v93
    v_exp_f32 v94, v94
    v_exp_f32 v95, v95
    v_smfmac_f32_32x32x32_bf16 v[24:39], a[36:39], v[144:151], v168
    v_exp_f32 v96, v96
    v_exp_f32 v97, v97
    v_exp_f32 v98, v98
    v_exp_f32 v99, v99
    v_smfmac_f32_32x32x32_bf16 v[56:71], a[36:39], v[160:167], v168
    v_exp_f32 v100, v100
    v_exp_f32 v101, v101
    v_exp_f32 v102, v102
    v_exp_f32 v103, v103
    s_setprio 1
    s_add_u32 m0, m0, 4096
    s_add_u32 s37, s37, 4096
    buffer_load_dwordx4 v173, s[28:31], s37 offen lds
    v_mfma_f32_32x32x4_2b_bf16 v[136:167], a[24:25], a[18:19], 4.0 cbsz:1 abid:0
    ds_read_b64 a[24:25], v169 offset:3872
    v_exp_f32 v104, v104
    v_exp_f32 v105, v105
    v_exp_f32 v106, v106
    v_exp_f32 v107, v107
    v_exp_f32 v108, v108
    v_exp_f32 v109, v109
    v_exp_f32 v110, v110
    v_exp_f32 v111, v111
    v_smfmac_f32_32x32x32_bf16 v[24:39], a[40:43], v[72:79], v168
    v_exp_f32 v112, v112
    v_exp_f32 v113, v113
    v_exp_f32 v114, v114
    v_exp_f32 v115, v115
    v_smfmac_f32_32x32x32_bf16 v[56:71], a[40:43], v[88:95], v168
    ds_read_b64_tr_b16 a[32:33], v170 offset:2560
    ds_read_b64_tr_b16 a[34:35], v170 offset:2720
    v_exp_f32 v116, v116
    v_exp_f32 v117, v117
    v_exp_f32 v118, v118
    v_exp_f32 v119, v119
    v_mfma_f32_32x32x16_bf16 v[136:151], a[20:23], a[8:11], v[136:151]
    ds_read_b64_tr_b16 a[36:37], v170 offset:3200
    ds_read_b64_tr_b16 a[38:39], v170 offset:3360
    buffer_load_dwordx4 v173, s[28:31], s37 offen offset:2048 lds
    v_exp_f32 v120, v120
    v_exp_f32 v121, v121
    v_exp_f32 v122, v122
    v_exp_f32 v123, v123
    v_mfma_f32_32x32x16_bf16 v[152:167], a[20:23], a[12:15], v[152:167]
    ds_read_b64 a[20:21], v169 offset:3840
    ds_read_b64 a[22:23], v169 offset:3848
    v_exp_f32 v124, v124
    v_exp_f32 v125, v125
    v_exp_f32 v126, v126
    v_exp_f32 v127, v127
    v_smfmac_f32_32x32x32_bf16 v[24:39], a[44:47], v[80:87], v168
    v_exp_f32 v128, v128
    v_exp_f32 v129, v129
    v_exp_f32 v130, v130
    v_exp_f32 v131, v131
    v_smfmac_f32_32x32x32_bf16 v[56:71], a[44:47], v[96:103], v168
    v_exp_f32 v132, v132
    v_exp_f32 v133, v133
    v_exp_f32 v134, v134
    v_exp_f32 v135, v135
    v_mad_u32_u24 v170, v171, s41, v170
    s_setprio 0
    s_add_u32 m0, m0, 4096
    s_add_u32 s37, s37, 4096
    buffer_load_dwordx4 v173, s[28:31], s37 offen lds
    s_waitcnt lgkmcnt(6)
    v_mfma_f32_32x32x4_2b_bf16 v[72:103], a[24:25], a[16:17], 4.0 cbsz:1 abid:0
    v_exp_f32 v136, v136
    v_exp_f32 v137, v137
    v_exp_f32 v138, v138
    v_exp_f32 v139, v139
    v_exp_f32 v140, v140
    v_exp_f32 v141, v141
    v_exp_f32 v142, v142
    v_exp_f32 v143, v143
    s_waitcnt lgkmcnt(4)
    v_smfmac_f32_32x32x32_bf16 v[8:23], a[32:35], v[104:111], v168
    v_exp_f32 v144, v144
    v_exp_f32 v145, v145
    v_exp_f32 v146, v146
    v_exp_f32 v147, v147
    v_smfmac_f32_32x32x32_bf16 v[40:55], a[32:35], v[120:127], v168
    v_exp_f32 v148, v148
    v_exp_f32 v149, v149
    v_exp_f32 v150, v150
    v_exp_f32 v151, v151
    s_waitcnt lgkmcnt(0)
    v_mfma_f32_32x32x16_bf16 v[72:87], a[20:23], a[0:3], v[72:87]
    buffer_load_dwordx4 v173, s[28:31], s37 offen offset:2048 lds
    v_exp_f32 v152, v152
    v_exp_f32 v153, v153
    v_exp_f32 v154, v154
    v_exp_f32 v155, v155
    v_mfma_f32_32x32x16_bf16 v[88:103], a[20:23], a[4:7], v[88:103]
    v_exp_f32 v156, v156
    v_exp_f32 v157, v157
    v_exp_f32 v158, v158
    v_exp_f32 v159, v159
    v_smfmac_f32_32x32x32_bf16 v[8:23], a[36:39], v[112:119], v168
    v_exp_f32 v160, v160
    v_exp_f32 v161, v161
    v_exp_f32 v162, v162
    v_exp_f32 v163, v163
    v_smfmac_f32_32x32x32_bf16 v[40:55], a[36:39], v[128:135], v168
    v_exp_f32 v164, v164
    v_exp_f32 v165, v165
    v_exp_f32 v166, v166
    v_exp_f32 v167, v167
    s_waitcnt vmcnt(4)
    s_mov_b64 exec, 1
    ds_add_u32 v174, v171 offset:3848
    s_mov_b64 exec, -1
    s_setprio 3
    s_add_u32 m0, m0, 4096
    s_add_u32 s37, s37, 4096
    buffer_load_dwordx4 v173, s[28:31], s37 offen lds
    v_mfma_f32_32x32x4_2b_bf16 v[104:135], a[24:25], a[18:19], 4.0 cbsz:1 abid:0
    ds_read_b64 a[24:25], v169 offset:5152
    v_exp_f32 v72, v72
    v_exp_f32 v73, v73
    v_exp_f32 v74, v74
    v_exp_f32 v75, v75
    v_exp_f32 v76, v76
    v_exp_f32 v77, v77
    v_exp_f32 v78, v78
    v_exp_f32 v79, v79
    v_smfmac_f32_32x32x32_bf16 v[24:39], a[32:35], v[136:143], v168
    v_exp_f32 v80, v80
    v_exp_f32 v81, v81
    v_exp_f32 v82, v82
    v_exp_f32 v83, v83
    v_smfmac_f32_32x32x32_bf16 v[56:71], a[32:35], v[152:159], v168
    ds_read_b64_tr_b16 a[32:33], v170 offset:0
    ds_read_b64_tr_b16 a[34:35], v170 offset:160
    v_exp_f32 v84, v84
    v_exp_f32 v85, v85
    v_exp_f32 v86, v86
    v_exp_f32 v87, v87
    v_mfma_f32_32x32x16_bf16 v[104:119], a[20:23], a[8:11], v[104:119]
    buffer_load_dwordx4 v173, s[28:31], s37 offen offset:2048 lds
    v_exp_f32 v88, v88
    v_exp_f32 v89, v89
    v_exp_f32 v90, v90
    v_exp_f32 v91, v91
    v_mfma_f32_32x32x16_bf16 v[120:135], a[20:23], a[12:15], v[120:135]
    ds_read_b64 a[20:21], v169 offset:5120
    ds_read_b64 a[22:23], v169 offset:5128
    v_exp_f32 v92, v92
    v_exp_f32 v93, v93
    v_exp_f32 v94, v94
    v_exp_f32 v95, v95
    v_smfmac_f32_32x32x32_bf16 v[24:39], a[36:39], v[144:151], v168
    v_exp_f32 v96, v96
    v_exp_f32 v97, v97
    v_exp_f32 v98, v98
    v_exp_f32 v99, v99
    v_smfmac_f32_32x32x32_bf16 v[56:71], a[36:39], v[160:167], v168
    ds_read_b64_tr_b16 a[36:37], v170 offset:640
    ds_read_b64_tr_b16 a[38:39], v170 offset:800
    v_exp_f32 v100, v100
    v_exp_f32 v101, v101
    v_exp_f32 v102, v102
    v_exp_f32 v103, v103
    s_setprio 2
    s_add_u32 m0, m0, 4096
    s_add_u32 s37, s37, 4096
    buffer_load_dwordx4 v173, s[28:31], s37 offen lds
    s_waitcnt lgkmcnt(6)
    v_mfma_f32_32x32x4_2b_bf16 v[136:167], a[24:25], a[16:17], 4.0 cbsz:1 abid:0
    v_exp_f32 v104, v104
    v_exp_f32 v105, v105
    v_exp_f32 v106, v106
    v_exp_f32 v107, v107
    v_exp_f32 v108, v108
    v_exp_f32 v109, v109
    v_exp_f32 v110, v110
    v_exp_f32 v111, v111
    s_waitcnt lgkmcnt(4)
    v_smfmac_f32_32x32x32_bf16 v[8:23], a[32:35], v[72:79], v168
    v_exp_f32 v112, v112
    v_exp_f32 v113, v113
    v_exp_f32 v114, v114
    v_exp_f32 v115, v115
    v_smfmac_f32_32x32x32_bf16 v[40:55], a[32:35], v[88:95], v168
    v_exp_f32 v116, v116
    v_exp_f32 v117, v117
    v_exp_f32 v118, v118
    v_exp_f32 v119, v119
    s_waitcnt lgkmcnt(2)
    v_mfma_f32_32x32x16_bf16 v[136:151], a[20:23], a[0:3], v[136:151]
    buffer_load_dwordx4 v173, s[28:31], s37 offen offset:2048 lds
    v_exp_f32 v120, v120
    v_exp_f32 v121, v121
    v_exp_f32 v122, v122
    v_exp_f32 v123, v123
    v_mfma_f32_32x32x16_bf16 v[152:167], a[20:23], a[4:7], v[152:167]
    v_exp_f32 v124, v124
    v_exp_f32 v125, v125
    v_exp_f32 v126, v126
    v_exp_f32 v127, v127
    s_waitcnt lgkmcnt(0)
    v_smfmac_f32_32x32x32_bf16 v[8:23], a[36:39], v[80:87], v168
    v_exp_f32 v128, v128
    v_exp_f32 v129, v129
    v_exp_f32 v130, v130
    v_exp_f32 v131, v131
    v_smfmac_f32_32x32x32_bf16 v[40:55], a[36:39], v[96:103], v168
    v_exp_f32 v132, v132
    v_exp_f32 v133, v133
    v_exp_f32 v134, v134
    v_exp_f32 v135, v135
    s_setprio 2
    ds_read_b32 v7, v174 offset:3848
    s_add_u32 m0, m0, 4096
    s_add_u32 s37, s37, 4096
    buffer_load_dwordx4 v173, s[28:31], s37 offen lds
    v_mfma_f32_32x32x4_2b_bf16 v[72:103], a[24:25], a[18:19], 4.0 cbsz:1 abid:0
    ds_read_b64 a[24:25], v169 offset:6432
    v_exp_f32 v136, v136
    v_exp_f32 v137, v137
    v_exp_f32 v138, v138
    v_exp_f32 v139, v139
    v_exp_f32 v140, v140
    v_exp_f32 v141, v141
    v_exp_f32 v142, v142
    v_exp_f32 v143, v143
    v_smfmac_f32_32x32x32_bf16 v[24:39], a[32:35], v[104:111], v168
    v_exp_f32 v144, v144
    v_exp_f32 v145, v145
    v_exp_f32 v146, v146
    v_exp_f32 v147, v147
    v_smfmac_f32_32x32x32_bf16 v[56:71], a[32:35], v[120:127], v168
    ds_read_b64_tr_b16 a[32:33], v170 offset:1280
    ds_read_b64_tr_b16 a[34:35], v170 offset:1440
    v_exp_f32 v148, v148
    v_exp_f32 v149, v149
    v_exp_f32 v150, v150
    v_exp_f32 v151, v151
    v_mfma_f32_32x32x16_bf16 v[72:87], a[20:23], a[8:11], v[72:87]
    buffer_load_dwordx4 v173, s[28:31], s37 offen offset:2048 lds
    v_exp_f32 v152, v152
    v_exp_f32 v153, v153
    v_exp_f32 v154, v154
    v_exp_f32 v155, v155
    v_mfma_f32_32x32x16_bf16 v[88:103], a[20:23], a[12:15], v[88:103]
    ds_read_b64 a[20:21], v169 offset:6400
    ds_read_b64 a[22:23], v169 offset:6408
    v_exp_f32 v156, v156
    v_exp_f32 v157, v157
    v_exp_f32 v158, v158
    v_exp_f32 v159, v159
    v_smfmac_f32_32x32x32_bf16 v[24:39], a[36:39], v[112:119], v168
L_chk0:
    s_waitcnt lgkmcnt(5)
    v_readfirstlane_b32 s42, v7
    s_nop 0
    s_cmp_eq_u32 s42, 8
    s_cbranch_scc0 L_retry0
    v_exp_f32 v160, v160
    v_exp_f32 v161, v161
    v_exp_f32 v162, v162
    v_exp_f32 v163, v163
    v_smfmac_f32_32x32x32_bf16 v[56:71], a[36:39], v[128:135], v168
    ds_read_b64_tr_b16 a[36:37], v170 offset:1920
    ds_read_b64_tr_b16 a[38:39], v170 offset:2080
    v_exp_f32 v164, v164
    v_exp_f32 v165, v165
    v_exp_f32 v166, v166
    v_exp_f32 v167, v167
    s_movk_i32 s42, 2560
    v_mad_u32_u24 v170, v171, s42, v170
    s_mov_b32 s40, 9
    s_mov_b32 s38, 0xc0800000
    s_mov_b32 s74, 0x32000000
    s_lshl_b32 s42, s32, 4
    s_add_u32 s42, s42, 3720
    s_xor_b32 s43, s42, 16
    v_mov_b32 v186, s42
    v_mov_b32 v187, s43
L_loop:
    s_setprio 1
    s_bitcmp1_b32 320, s40
    s_cbranch_scc1 L_bar
L_bar_ret:
    s_waitcnt lgkmcnt(6)
    v_mfma_f32_32x32x4_2b_bf16 v[104:135], a[24:25], a[16:17], 4.0 cbsz:1 abid:0
    v_exp_f32 v72, v72
    v_exp_f32 v73, v73
    v_exp_f32 v74, v74
    v_exp_f32 v75, v75
    v_exp_f32 v76, v76
    v_exp_f32 v77, v77
    v_exp_f32 v78, v78
    v_exp_f32 v79, v79
    s_waitcnt lgkmcnt(4)
    v_smfmac_f32_32x32x32_bf16 v[8:23], a[32:35], v[136:143], v168
    v_exp_f32 v80, v80
    v_exp_f32 v81, v81
    v_exp_f32 v82, v82
    v_exp_f32 v83, v83
    v_smfmac_f32_32x32x32_bf16 v[40:55], a[32:35], v[152:159], v168
    v_exp_f32 v84, v84
    v_exp_f32 v85, v85
    v_exp_f32 v86, v86
    v_exp_f32 v87, v87
    s_waitcnt lgkmcnt(2)
    v_mfma_f32_32x32x16_bf16 v[104:119], a[20:23], a[0:3], v[104:119]
    v_exp_f32 v88, v88
    v_exp_f32 v89, v89
    v_exp_f32 v90, v90
    v_exp_f32 v91, v91
    v_mfma_f32_32x32x16_bf16 v[120:135], a[20:23], a[4:7], v[120:135]
    v_exp_f32 v92, v92
    v_exp_f32 v93, v93
    v_exp_f32 v94, v94
    v_exp_f32 v95, v95
    s_waitcnt lgkmcnt(0)
    v_smfmac_f32_32x32x32_bf16 v[8:23], a[36:39], v[144:151], v168
    v_exp_f32 v96, v96
    v_exp_f32 v97, v97
    v_exp_f32 v98, v98
    v_exp_f32 v99, v99
    v_smfmac_f32_32x32x32_bf16 v[40:55], a[36:39], v[160:167], v168
    v_exp_f32 v100, v100
    v_exp_f32 v101, v101
    v_exp_f32 v102, v102
    v_exp_f32 v103, v103
    s_setprio 1
    v_mfma_f32_32x32x4_2b_bf16 v[136:167], a[24:25], a[18:19], 4.0 cbsz:1 abid:0
    ds_read_b64 a[24:25], v169 offset:7712
    v_exp_f32 v104, v104
    v_exp_f32 v105, v105
    v_exp_f32 v106, v106
    v_exp_f32 v107, v107
    v_exp_f32 v108, v108
    v_exp_f32 v109, v109
    v_exp_f32 v110, v110
    v_exp_f32 v111, v111
    v_smfmac_f32_32x32x32_bf16 v[24:39], a[32:35], v[72:79], v168
    v_exp_f32 v112, v112
    v_exp_f32 v113, v113
    v_exp_f32 v114, v114
    v_exp_f32 v115, v115
    v_smfmac_f32_32x32x32_bf16 v[56:71], a[32:35], v[88:95], v168
    ds_read_b64_tr_b16 a[32:33], v170 offset:0
    ds_read_b64_tr_b16 a[34:35], v170 offset:160
    v_exp_f32 v116, v116
    v_exp_f32 v117, v117
    v_exp_f32 v118, v118
    v_exp_f32 v119, v119
    v_mfma_f32_32x32x16_bf16 v[136:151], a[20:23], a[8:11], v[136:151]
    v_exp_f32 v120, v120
    v_exp_f32 v121, v121
    v_exp_f32 v122, v122
    v_exp_f32 v123, v123
    v_mfma_f32_32x32x16_bf16 v[152:167], a[20:23], a[12:15], v[152:167]
    ds_read_b64 a[20:21], v169 offset:7680
    ds_read_b64 a[22:23], v169 offset:7688
    v_exp_f32 v124, v124
    v_exp_f32 v125, v125
    v_exp_f32 v126, v126
    v_exp_f32 v127, v127
    v_smfmac_f32_32x32x32_bf16 v[24:39], a[36:39], v[80:87], v168
    v_exp_f32 v128, v128
    v_exp_f32 v129, v129
    v_exp_f32 v130, v130
    v_exp_f32 v131, v131
    v_smfmac_f32_32x32x32_bf16 v[56:71], a[36:39], v[96:103], v168
    ds_read_b64_tr_b16 a[36:37], v170 offset:640
    ds_read_b64_tr_b16 a[38:39], v170 offset:800
    v_exp_f32 v132, v132
    v_exp_f32 v133, v133
    v_exp_f32 v134, v134
    v_exp_f32 v135, v135
    s_setprio 0
    s_waitcnt lgkmcnt(6)
    v_mfma_f32_32x32x4_2b_bf16 v[72:103], a[24:25], a[16:17], 4.0 cbsz:1 abid:0
    v_exp_f32 v136, v136
    v_exp_f32 v137, v137
    v_exp_f32 v138, v138
    v_exp_f32 v139, v139
    v_exp_f32 v140, v140
    v_exp_f32 v141, v141
    v_exp_f32 v142, v142
    v_exp_f32 v143, v143
    s_waitcnt lgkmcnt(4)
    v_smfmac_f32_32x32x32_bf16 v[8:23], a[32:35], v[104:111], v168
    v_exp_f32 v144, v144
    v_exp_f32 v145, v145
    v_exp_f32 v146, v146
    v_exp_f32 v147, v147
    v_smfmac_f32_32x32x32_bf16 v[40:55], a[32:35], v[120:127], v168
    v_exp_f32 v148, v148
    v_exp_f32 v149, v149
    v_exp_f32 v150, v150
    v_exp_f32 v151, v151
    s_waitcnt lgkmcnt(2)
    v_mfma_f32_32x32x16_bf16 v[72:87], a[20:23], a[0:3], v[72:87]
    v_exp_f32 v152, v152
    v_exp_f32 v153, v153
    v_exp_f32 v154, v154
    v_exp_f32 v155, v155
    v_mfma_f32_32x32x16_bf16 v[88:103], a[20:23], a[4:7], v[88:103]
    v_exp_f32 v156, v156
    v_exp_f32 v157, v157
    v_exp_f32 v158, v158
    v_exp_f32 v159, v159
    s_waitcnt lgkmcnt(0)
    v_smfmac_f32_32x32x32_bf16 v[8:23], a[36:39], v[112:119], v168
    v_exp_f32 v160, v160
    v_exp_f32 v161, v161
    v_exp_f32 v162, v162
    v_exp_f32 v163, v163
    v_smfmac_f32_32x32x32_bf16 v[40:55], a[36:39], v[128:135], v168
    v_exp_f32 v164, v164
    v_exp_f32 v165, v165
    v_exp_f32 v166, v166
    v_exp_f32 v167, v167
    s_setprio 3
    v_mfma_f32_32x32x4_2b_bf16 v[104:135], a[24:25], a[18:19], 4.0 cbsz:1 abid:0
    ds_read_b64 a[24:25], v169 offset:8992
    v_exp_f32 v72, v72
    v_exp_f32 v73, v73
    v_exp_f32 v74, v74
    v_exp_f32 v75, v75
    v_exp_f32 v76, v76
    v_exp_f32 v77, v77
    v_exp_f32 v78, v78
    v_exp_f32 v79, v79
    v_smfmac_f32_32x32x32_bf16 v[24:39], a[32:35], v[136:143], v168
    v_exp_f32 v80, v80
    v_exp_f32 v81, v81
    v_exp_f32 v82, v82
    v_exp_f32 v83, v83
    v_smfmac_f32_32x32x32_bf16 v[56:71], a[32:35], v[152:159], v168
    ds_read_b64_tr_b16 a[32:33], v170 offset:1280
    ds_read_b64_tr_b16 a[34:35], v170 offset:1440
    v_exp_f32 v84, v84
    v_exp_f32 v85, v85
    v_exp_f32 v86, v86
    v_exp_f32 v87, v87
    v_mfma_f32_32x32x16_bf16 v[104:119], a[20:23], a[8:11], v[104:119]
    v_exp_f32 v88, v88
    v_exp_f32 v89, v89
    v_exp_f32 v90, v90
    v_exp_f32 v91, v91
    v_mfma_f32_32x32x16_bf16 v[120:135], a[20:23], a[12:15], v[120:135]
    ds_read_b64 a[20:21], v169 offset:8960
    ds_read_b64 a[22:23], v169 offset:8968
    v_exp_f32 v92, v92
    v_exp_f32 v93, v93
    v_exp_f32 v94, v94
    v_exp_f32 v95, v95
    v_smfmac_f32_32x32x32_bf16 v[24:39], a[36:39], v[144:151], v168
    v_exp_f32 v96, v96
    v_exp_f32 v97, v97
    v_exp_f32 v98, v98
    v_exp_f32 v99, v99
    v_smfmac_f32_32x32x32_bf16 v[56:71], a[36:39], v[160:167], v168
    ds_read_b64_tr_b16 a[36:37], v170 offset:1920
    ds_read_b64_tr_b16 a[38:39], v170 offset:2080
    v_exp_f32 v100, v100
    v_exp_f32 v101, v101
    v_exp_f32 v102, v102
    v_exp_f32 v103, v103
    s_setprio 2
    s_waitcnt lgkmcnt(6)
    v_mfma_f32_32x32x4_2b_bf16 v[136:167], a[24:25], a[16:17], 4.0 cbsz:1 abid:0
    v_exp_f32 v104, v104
    v_exp_f32 v105, v105
    v_exp_f32 v106, v106
    v_exp_f32 v107, v107
    v_exp_f32 v108, v108
    v_exp_f32 v109, v109
    v_exp_f32 v110, v110
    v_exp_f32 v111, v111
    s_waitcnt lgkmcnt(4)
    v_smfmac_f32_32x32x32_bf16 v[8:23], a[32:35], v[72:79], v168
    v_exp_f32 v112, v112
    v_exp_f32 v113, v113
    v_exp_f32 v114, v114
    v_exp_f32 v115, v115
    v_smfmac_f32_32x32x32_bf16 v[40:55], a[32:35], v[88:95], v168
    v_exp_f32 v116, v116
    v_exp_f32 v117, v117
    v_exp_f32 v118, v118
    v_exp_f32 v119, v119
    s_waitcnt lgkmcnt(2)
    v_mfma_f32_32x32x16_bf16 v[136:151], a[20:23], a[0:3], v[136:151]
    v_exp_f32 v120, v120
    v_exp_f32 v121, v121
    v_exp_f32 v122, v122
    v_exp_f32 v123, v123
    v_mfma_f32_32x32x16_bf16 v[152:167], a[20:23], a[4:7], v[152:167]
    v_exp_f32 v124, v124
    v_exp_f32 v125, v125
    v_exp_f32 v126, v126
    v_exp_f32 v127, v127
    s_waitcnt lgkmcnt(0)
    v_smfmac_f32_32x32x32_bf16 v[8:23], a[36:39], v[80:87], v168
    v_exp_f32 v128, v128
    v_exp_f32 v129, v129
    v_exp_f32 v130, v130
    v_exp_f32 v131, v131
    v_smfmac_f32_32x32x32_bf16 v[40:55], a[36:39], v[96:103], v168
    v_exp_f32 v132, v132
    v_exp_f32 v133, v133
    v_exp_f32 v134, v134
    v_exp_f32 v135, v135
    s_setprio 2
    v_mfma_f32_32x32x4_2b_bf16 v[72:103], a[24:25], a[18:19], 4.0 cbsz:1 abid:0
    ds_read_b64 a[24:25], v169 offset:10272
    v_exp_f32 v136, v136
    v_exp_f32 v137, v137
    v_exp_f32 v138, v138
    v_exp_f32 v139, v139
    v_exp_f32 v140, v140
    v_exp_f32 v141, v141
    v_exp_f32 v142, v142
    v_exp_f32 v143, v143
    v_smfmac_f32_32x32x32_bf16 v[24:39], a[32:35], v[104:111], v168
    v_exp_f32 v144, v144
    v_exp_f32 v145, v145
    v_exp_f32 v146, v146
    v_exp_f32 v147, v147
    v_smfmac_f32_32x32x32_bf16 v[56:71], a[32:35], v[120:127], v168
    ds_read_b64_tr_b16 a[32:33], v170 offset:2560
    ds_read_b64_tr_b16 a[34:35], v170 offset:2720
    v_exp_f32 v148, v148
    v_exp_f32 v149, v149
    v_exp_f32 v150, v150
    v_exp_f32 v151, v151
    v_mfma_f32_32x32x16_bf16 v[72:87], a[20:23], a[8:11], v[72:87]
    v_exp_f32 v152, v152
    v_exp_f32 v153, v153
    v_exp_f32 v154, v154
    v_exp_f32 v155, v155
    v_mfma_f32_32x32x16_bf16 v[88:103], a[20:23], a[12:15], v[88:103]
    ds_read_b64 a[20:21], v169 offset:10240
    ds_read_b64 a[22:23], v169 offset:10248
    v_exp_f32 v156, v156
    v_exp_f32 v157, v157
    v_exp_f32 v158, v158
    v_exp_f32 v159, v159
    v_smfmac_f32_32x32x32_bf16 v[24:39], a[36:39], v[112:119], v168
    s_sub_u32 s40, s40, 1
    v_exp_f32 v160, v160
    v_exp_f32 v161, v161
    v_exp_f32 v162, v162
    v_exp_f32 v163, v163
    v_smfmac_f32_32x32x32_bf16 v[56:71], a[36:39], v[128:135], v168
    ds_read_b64_tr_b16 a[36:37], v170 offset:3200
    ds_read_b64_tr_b16 a[38:39], v170 offset:3360
    v_exp_f32 v164, v164
    v_exp_f32 v165, v165
    v_exp_f32 v166, v166
    v_exp_f32 v167, v167
    v_add_u32 v169, s41, v169
    v_mad_u32_u24 v170, v171, s41, v170
    s_cmp_lg_u32 s40, 0
    s_cbranch_scc1 L_loop
    s_setprio 3
    s_waitcnt lgkmcnt(4)
    v_smfmac_f32_32x32x32_bf16 v[40:55], a[32:35], v[152:159], v168
    v_exp_f32 v88, v88
    v_exp_f32 v89, v89
    v_exp_f32 v90, v90
    s_waitcnt lgkmcnt(0)
    v_smfmac_f32_32x32x32_bf16 v[40:55], a[36:39], v[160:167], v168
    ds_read_b32 v7, v174 offset:3880
    v_exp_f32 v91, v91
    v_exp_f32 v92, v92
    v_exp_f32 v93, v93
    v_smfmac_f32_32x32x32_bf16 v[8:23], a[32:35], v[136:143], v168
    v_exp_f32 v94, v94
    v_exp_f32 v95, v95
    v_exp_f32 v96, v96
    v_exp_f32 v97, v97
    v_smfmac_f32_32x32x32_bf16 v[56:71], a[32:35], v[88:95], v168
    v_exp_f32 v98, v98
    v_exp_f32 v99, v99
    v_exp_f32 v100, v100
L_chk2:
    s_waitcnt lgkmcnt(0)
    v_readfirstlane_b32 s42, v7
    s_nop 0
    s_cmp_eq_u32 s42, 8
    s_cbranch_scc0 L_retry2
    ds_write_b128 v175, v[40:43] offset:0
    v_exp_f32 v101, v101
    v_smfmac_f32_32x32x32_bf16 v[8:23], a[36:39], v[144:151], v168
    ds_write_b128 v175, v[44:47] offset:1024
    v_exp_f32 v102, v102
    v_exp_f32 v103, v103
    ds_write_b128 v175, v[48:51] offset:2048
    v_exp_f32 v72, v72
    v_smfmac_f32_32x32x32_bf16 v[56:71], a[36:39], v[96:103], v168
    v_exp_f32 v73, v73
    v_exp_f32 v74, v74
    v_exp_f32 v75, v75
    v_exp_f32 v76, v76
    v_exp_f32 v77, v77
    v_exp_f32 v78, v78
    v_exp_f32 v79, v79
    v_exp_f32 v80, v80
    v_exp_f32 v81, v81
    v_smfmac_f32_32x32x32_bf16 v[24:39], a[32:35], v[72:79], v168
    v_exp_f32 v82, v82
    v_exp_f32 v83, v83
    ds_write_b128 v175, v[56:59] offset:3072
    ds_write_b128 v175, v[60:63] offset:4096
    ds_write_b128 v175, v[64:67] offset:5120
    v_exp_f32 v84, v84
    v_exp_f32 v85, v85
    s_waitcnt lgkmcnt(0)
    s_mov_b64 exec, 1
    ds_write_b32 v186, v168 offset:0
    s_mov_b64 exec, -1
    ds_read_b32 v6, v187 offset:0
    v_exp_f32 v86, v86
    v_exp_f32 v87, v87
    s_nop 1
    v_smfmac_f32_32x32x32_bf16 v[24:39], a[36:39], v[80:87], v168
L_poll0:
    s_waitcnt lgkmcnt(0)
    v_readfirstlane_b32 s42, v6
    s_nop 0
    s_cmp_lg_u32 s42, 0
    s_cbranch_scc0 L_wait0
    ds_read_b128 v[112:115], v181 offset:2048
    ds_read_b128 v[104:107], v181 offset:0
    ds_read_b128 v[108:111], v181 offset:1024
    ds_read_b128 v[128:131], v181 offset:5120
    ds_read_b128 v[120:123], v181 offset:3072
    ds_read_b128 v[124:127], v181 offset:4096
    s_waitcnt lgkmcnt(5)
    v_pk_add_f32 v[16:17], v[16:17], v[112:113]
    v_pk_add_f32 v[18:19], v[18:19], v[114:115]
    s_waitcnt lgkmcnt(4)
    v_pk_add_f32 v[8:9], v[8:9], v[104:105]
    v_pk_add_f32 v[10:11], v[10:11], v[106:107]
    s_waitcnt lgkmcnt(3)
    v_pk_add_f32 v[12:13], v[12:13], v[108:109]
    v_pk_add_f32 v[14:15], v[14:15], v[110:111]
    v_mov_b32 v1, v16
    s_nop 1
    v_permlane32_swap_b32 v16, v1
    v_rcp_f32 v176, v1
    s_waitcnt lgkmcnt(2)
    v_pk_add_f32 v[32:33], v[32:33], v[128:129]
    v_pk_mul_f32 v[8:9], v[8:9], v[176:177] op_sel_hi:[1,0]
    v_pk_mul_f32 v[10:11], v[10:11], v[176:177] op_sel_hi:[1,0]
    v_pk_mul_f32 v[12:13], v[12:13], v[176:177] op_sel_hi:[1,0]
    v_pk_mul_f32 v[14:15], v[14:15], v[176:177] op_sel_hi:[1,0]
    v_pk_mul_f32 v[16:17], v[16:17], v[176:177] op_sel_hi:[1,0]
    v_pk_mul_f32 v[18:19], v[18:19], v[176:177] op_sel_hi:[1,0]
    v_cvt_pk_bf16_f32 v8, v8, v9
    v_cvt_pk_bf16_f32 v9, v10, v11
    v_cvt_pk_bf16_f32 v10, v12, v13
    v_cvt_pk_bf16_f32 v11, v14, v15
    v_cvt_pk_bf16_f32 v12, v16, v17
    v_cvt_pk_bf16_f32 v13, v18, v19
    ds_write_b64 v182, v[8:9] offset:0
    ds_write_b64 v182, v[10:11] offset:16
    ds_write_b64 v183, v[12:13] offset:32
    v_pk_add_f32 v[34:35], v[34:35], v[130:131]
    s_waitcnt lgkmcnt(4)
    v_pk_add_f32 v[24:25], v[24:25], v[120:121]
    v_pk_add_f32 v[26:27], v[26:27], v[122:123]
    s_waitcnt lgkmcnt(3)
    v_pk_add_f32 v[28:29], v[28:29], v[124:125]
    v_pk_add_f32 v[30:31], v[30:31], v[126:127]
    v_mov_b32 v3, v32
    s_waitcnt lgkmcnt(0)
    ds_read_b128 v[104:107], v181
    v_permlane32_swap_b32 v32, v3
    v_rcp_f32 v178, v3
    s_nop 0
    v_pk_mul_f32 v[24:25], v[24:25], v[178:179] op_sel_hi:[1,0]
    v_pk_mul_f32 v[26:27], v[26:27], v[178:179] op_sel_hi:[1,0]
    v_pk_mul_f32 v[28:29], v[28:29], v[178:179] op_sel_hi:[1,0]
    v_pk_mul_f32 v[30:31], v[30:31], v[178:179] op_sel_hi:[1,0]
    v_pk_mul_f32 v[32:33], v[32:33], v[178:179] op_sel_hi:[1,0]
    v_pk_mul_f32 v[34:35], v[34:35], v[178:179] op_sel_hi:[1,0]
    v_cvt_pk_bf16_f32 v24, v24, v25
    v_cvt_pk_bf16_f32 v25, v26, v27
    v_cvt_pk_bf16_f32 v26, v28, v29
    v_cvt_pk_bf16_f32 v27, v30, v31
    v_cvt_pk_bf16_f32 v28, v32, v33
    v_cvt_pk_bf16_f32 v29, v34, v35
    ds_write_b64 v182, v[24:25] offset:3072
    ds_write_b64 v182, v[26:27] offset:3088
    ds_write_b64 v183, v[28:29] offset:3104
    s_waitcnt lgkmcnt(3)
    buffer_store_dwordx4 v[104:107], v173, s[24:27], s35 offen sc1
    s_waitcnt lgkmcnt(0)
    ds_read_b128 v[120:123], v181 offset:3072
    ds_read_b128 v[108:111], v184 offset:1024
    s_waitcnt lgkmcnt(1)
    buffer_store_dwordx4 v[120:123], v173, s[24:27], s35 offen offset:2560 sc1
    s_mov_b32 exec_hi, 0
    s_waitcnt lgkmcnt(0)
    buffer_store_dwordx4 v[108:111], v185, s[24:27], s35 offen offset:1024 sc1
    s_mov_b32 exec_hi, -1
    v_add_u32 v6, s38, v1
    v_mov_b32 v7, 0
    v_cmp_gt_u32 vcc, s74, v6
    v_dot2_f32_bf16 v7, v8, 0, v7
    v_dot2_f32_bf16 v7, v9, 0, v7
    v_dot2_f32_bf16 v7, v10, 0, v7
    v_dot2_f32_bf16 v7, v11, 0, v7
    v_dot2_f32_bf16 v7, v12, 0, v7
    v_dot2_f32_bf16 v7, v13, 0, v7
    s_and_b64 s[46:47], s[46:47], vcc
    s_nop 1
    v_cmp_o_f32 vcc, v7, v7
    v_add_u32 v6, s38, v3
    s_and_b64 s[46:47], s[46:47], vcc
    v_mov_b32 v7, 0
    v_cmp_gt_u32 vcc, s74, v6
    v_dot2_f32_bf16 v7, v24, 0, v7
    v_dot2_f32_bf16 v7, v25, 0, v7
    v_dot2_f32_bf16 v7, v26, 0, v7
    v_dot2_f32_bf16 v7, v27, 0, v7
    v_dot2_f32_bf16 v7, v28, 0, v7
    v_dot2_f32_bf16 v7, v29, 0, v7
    s_and_b64 s[46:47], s[46:47], vcc
    s_nop 1
    v_cmp_o_f32 vcc, v7, v7
    s_nop 1
    s_and_b64 s[46:47], s[46:47], vcc
    s_andn2_b64 vcc, exec, s[46:47]
    s_cbranch_scc1 L_slow
L_end:
    s_endpgm
L_wait0:
    ds_read_b32 v6, v187 offset:0
    s_waitcnt lgkmcnt(0)
    s_branch L_poll0
L_bar:
    s_cmp_eq_u32 s40, 8
    s_cbranch_scc0 L_bar2
    s_waitcnt vmcnt(0)
    s_mov_b64 exec, 1
    ds_add_u32 v174, v171 offset:3864
    s_mov_b64 exec, -1
    s_branch L_bar_ret
L_bar2:
    ds_read_b32 v7, v174 offset:3864
L_chk1:
    s_waitcnt lgkmcnt(0)
    v_readfirstlane_b32 s42, v7
    s_nop 0
    s_cmp_eq_u32 s42, 8
    s_cbranch_scc0 L_retry1
    s_mov_b64 exec, 1
    ds_add_u32 v174, v171 offset:3880
    s_mov_b64 exec, -1
    s_branch L_bar_ret
L_retry0:
    ds_read_b32 v7, v174 offset:3848
    s_waitcnt lgkmcnt(0)
    s_branch L_chk0
L_retry2:
    ds_read_b32 v7, v174 offset:3880
    s_waitcnt lgkmcnt(0)
    s_branch L_chk2
L_retry1:
    ds_read_b32 v7, v174 offset:3864
    s_waitcnt lgkmcnt(0)
    s_branch L_chk1
L_slow:
    s_waitcnt vmcnt(0) lgkmcnt(0)
    v_accvgpr_read_b32 v136, a16
    v_accvgpr_read_b32 v137, a17
    v_accvgpr_read_b32 v138, a18
    v_accvgpr_read_b32 v139, a19
    s_nop 1
    v_permlane32_swap_b32 v136, v138
    v_permlane32_swap_b32 v137, v139
    s_nop 1
    v_accvgpr_write_b32 a16, v136
    v_accvgpr_write_b32 a17, v137
    v_mov_b32 v162, 0xff800000
    v_mov_b32 v163, 0xff800000
    s_mov_b32 s42, s33
    s_add_u32 s43, s33, 81920
L_slow1:
    buffer_load_dwordx2 a[24:25], v172, s[16:19], s42 offen offset:32
    buffer_load_dwordx4 a[20:23], v172, s[16:19], s42 offen
    s_waitcnt vmcnt(0)
    v_mfma_f32_32x32x4_2b_bf16 v[72:103], a[24:25], a[16:17], 0 cbsz:1 abid:0
    s_nop 15
    s_nop 1
    v_mfma_f32_32x32x16_bf16 v[72:87], a[20:23], a[0:3], v[72:87]
    v_mfma_f32_32x32x16_bf16 v[88:103], a[20:23], a[8:11], v[88:103]
    s_nop 11
    v_max3_f32 v162, v72, v73, v162
    v_max3_f32 v162, v74, v75, v162
    v_max3_f32 v162, v76, v77, v162
    v_max3_f32 v162, v78, v79, v162
    v_max3_f32 v162, v80, v81, v162
    v_max3_f32 v162, v82, v83, v162
    v_max3_f32 v162, v84, v85, v162
    v_max3_f32 v162, v86, v87, v162
    v_max3_f32 v163, v88, v89, v163
    v_max3_f32 v163, v90, v91, v163
    v_max3_f32 v163, v92, v93, v163
    v_max3_f32 v163, v94, v95, v163
    v_max3_f32 v163, v96, v97, v163
    v_max3_f32 v163, v98, v99, v163
    v_max3_f32 v163, v100, v101, v163
    v_max3_f32 v163, v102, v103, v163
    s_add_u32 s42, s42, 1280
    s_cmp_lt_u32 s42, s43
    s_cbranch_scc1 L_slow1
    v_mov_b32 v164, v162
    v_mov_b32 v165, v163
    s_nop 1
    v_permlane32_swap_b32 v162, v164
    v_permlane32_swap_b32 v163, v165
    s_nop 1
    v_max_f32 v162, v162, v164
    v_max_f32 v163, v163, v165
    v_sub_f32 v104, 0, v162
    v_sub_f32 v120, 0, v163
    v_sub_f32 v105, 0, v162
    v_sub_f32 v121, 0, v163
    v_sub_f32 v106, 0, v162
    v_sub_f32 v122, 0, v163
    v_sub_f32 v107, 0, v162
    v_sub_f32 v123, 0, v163
    v_sub_f32 v108, 0, v162
    v_sub_f32 v124, 0, v163
    v_sub_f32 v109, 0, v162
    v_sub_f32 v125, 0, v163
    v_sub_f32 v110, 0, v162
    v_sub_f32 v126, 0, v163
    v_sub_f32 v111, 0, v162
    v_sub_f32 v127, 0, v163
    v_sub_f32 v112, 0, v162
    v_sub_f32 v128, 0, v163
    v_sub_f32 v113, 0, v162
    v_sub_f32 v129, 0, v163
    v_sub_f32 v114, 0, v162
    v_sub_f32 v130, 0, v163
    v_sub_f32 v115, 0, v162
    v_sub_f32 v131, 0, v163
    v_sub_f32 v116, 0, v162
    v_sub_f32 v132, 0, v163
    v_sub_f32 v117, 0, v162
    v_sub_f32 v133, 0, v163
    v_sub_f32 v118, 0, v162
    v_sub_f32 v134, 0, v163
    v_sub_f32 v119, 0, v162
    v_sub_f32 v135, 0, v163
    v_mov_b32 v8, 0
    v_mov_b32 v9, 0
    v_mov_b32 v10, 0
    v_mov_b32 v11, 0
    v_mov_b32 v12, 0
    v_mov_b32 v13, 0
    v_mov_b32 v14, 0
    v_mov_b32 v15, 0
    v_mov_b32 v16, 0
    v_mov_b32 v17, 0
    v_mov_b32 v18, 0
    v_mov_b32 v19, 0
    v_mov_b32 v20, 0
    v_mov_b32 v21, 0
    v_mov_b32 v22, 0
    v_mov_b32 v23, 0
    v_mov_b32 v24, 0
    v_mov_b32 v25, 0
    v_mov_b32 v26, 0
    v_mov_b32 v27, 0
    v_mov_b32 v28, 0
    v_mov_b32 v29, 0
    v_mov_b32 v30, 0
    v_mov_b32 v31, 0
    v_mov_b32 v32, 0
    v_mov_b32 v33, 0
    v_mov_b32 v34, 0
    v_mov_b32 v35, 0
    v_mov_b32 v36, 0
    v_mov_b32 v37, 0
    v_mov_b32 v38, 0
    v_mov_b32 v39, 0
    v_and_b32 v165, 31, v0
    v_bfe_u32 v164, v0, 5, 1
    v_mul_u32_u24 v164, 320, v164
    v_lshl_add_u32 v164, v165, 1, v164
    v_cmp_eq_u32 vcc, 20, v165
    v_mov_b32 v166, 0x3f803f80
    s_nop 0
    v_cndmask_b32 v166, 0, v166, vcc
    v_mov_b32 v152, v166
    v_mov_b32 v153, v166
    v_mov_b32 v154, v166
    v_mov_b32 v155, v166
    v_mov_b32 v156, v166
    v_mov_b32 v157, v166
    v_mov_b32 v158, v166
    v_mov_b32 v159, v166
    v_cmp_gt_u32 s[44:45], 20, v165
    s_mov_b32 s42, s33
L_slow2:
    buffer_load_dwordx2 a[24:25], v172, s[16:19], s42 offen offset:32
    buffer_load_dwordx4 a[20:23], v172, s[16:19], s42 offen
    s_mov_b64 exec, s[44:45]
    buffer_load_ushort v136, v164, s[20:23], s42 offen offset:0
    buffer_load_ushort v137, v164, s[20:23], s42 offen offset:40
    buffer_load_ushort v138, v164, s[20:23], s42 offen offset:80
    buffer_load_ushort v139, v164, s[20:23], s42 offen offset:120
    buffer_load_ushort v140, v164, s[20:23], s42 offen offset:160
    buffer_load_ushort v141, v164, s[20:23], s42 offen offset:200
    buffer_load_ushort v142, v164, s[20:23], s42 offen offset:240
    buffer_load_ushort v143, v164, s[20:23], s42 offen offset:280
    buffer_load_ushort v144, v164, s[20:23], s42 offen offset:640
    buffer_load_ushort v145, v164, s[20:23], s42 offen offset:680
    buffer_load_ushort v146, v164, s[20:23], s42 offen offset:720
    buffer_load_ushort v147, v164, s[20:23], s42 offen offset:760
    buffer_load_ushort v148, v164, s[20:23], s42 offen offset:800
    buffer_load_ushort v149, v164, s[20:23], s42 offen offset:840
    buffer_load_ushort v150, v164, s[20:23], s42 offen offset:880
    buffer_load_ushort v151, v164, s[20:23], s42 offen offset:920
    s_waitcnt vmcnt(0)
    v_lshl_or_b32 v152, v137, 16, v136
    v_lshl_or_b32 v153, v139, 16, v138
    v_lshl_or_b32 v154, v141, 16, v140
    v_lshl_or_b32 v155, v143, 16, v142
    v_lshl_or_b32 v156, v145, 16, v144
    v_lshl_or_b32 v157, v147, 16, v146
    v_lshl_or_b32 v158, v149, 16, v148
    v_lshl_or_b32 v159, v151, 16, v150
    s_mov_b64 exec, -1
    s_nop 3
    v_mfma_f32_32x32x4_2b_bf16 v[72:103], a[24:25], a[16:17], v[104:135] cbsz:1 abid:0
    s_nop 15
    s_nop 1
    v_mfma_f32_32x32x16_bf16 v[72:87], a[20:23], a[0:3], v[72:87]
    v_mfma_f32_32x32x16_bf16 v[88:103], a[20:23], a[8:11], v[88:103]
    s_nop 11
    v_exp_f32 v72, v72
    v_exp_f32 v73, v73
    v_exp_f32 v74, v74
    v_exp_f32 v75, v75
    v_exp_f32 v76, v76
    v_exp_f32 v77, v77
    v_exp_f32 v78, v78
    v_exp_f32 v79, v79
    v_exp_f32 v80, v80
    v_exp_f32 v81, v81
    v_exp_f32 v82, v82
    v_exp_f32 v83, v83
    v_exp_f32 v84, v84
    v_exp_f32 v85, v85
    v_exp_f32 v86, v86
    v_exp_f32 v87, v87
    v_exp_f32 v88, v88
    v_exp_f32 v89, v89
    v_exp_f32 v90, v90
    v_exp_f32 v91, v91
    v_exp_f32 v92, v92
    v_exp_f32 v93, v93
    v_exp_f32 v94, v94
    v_exp_f32 v95, v95
    v_exp_f32 v96, v96
    v_exp_f32 v97, v97
    v_exp_f32 v98, v98
    v_exp_f32 v99, v99
    v_exp_f32 v100, v100
    v_exp_f32 v101, v101
    v_exp_f32 v102, v102
    v_exp_f32 v103, v103
    s_nop 1
    v_smfmac_f32_32x32x32_bf16 v[8:23], v[152:155], v[72:79], v168
    v_smfmac_f32_32x32x32_bf16 v[24:39], v[152:155], v[88:95], v168
    v_smfmac_f32_32x32x32_bf16 v[8:23], v[156:159], v[80:87], v168
    v_smfmac_f32_32x32x32_bf16 v[24:39], v[156:159], v[96:103], v168
    s_add_u32 s42, s42, 1280
    s_cmp_lt_u32 s42, s43
    s_cbranch_scc1 L_slow2
    s_nop 11
    v_mov_b32 v1, v16
    s_nop 1
    v_permlane32_swap_b32 v16, v1
    v_rcp_f32 v176, v1
    s_nop 0
    v_pk_mul_f32 v[8:9], v[8:9], v[176:177] op_sel_hi:[1,0]
    v_pk_mul_f32 v[10:11], v[10:11], v[176:177] op_sel_hi:[1,0]
    v_pk_mul_f32 v[12:13], v[12:13], v[176:177] op_sel_hi:[1,0]
    v_pk_mul_f32 v[14:15], v[14:15], v[176:177] op_sel_hi:[1,0]
    v_pk_mul_f32 v[16:17], v[16:17], v[176:177] op_sel_hi:[1,0]
    v_pk_mul_f32 v[18:19], v[18:19], v[176:177] op_sel_hi:[1,0]
    v_cvt_pk_bf16_f32 v8, v8, v9
    v_cvt_pk_bf16_f32 v9, v10, v11
    v_cvt_pk_bf16_f32 v10, v12, v13
    v_cvt_pk_bf16_f32 v11, v14, v15
    v_cvt_pk_bf16_f32 v12, v16, v17
    v_cvt_pk_bf16_f32 v13, v18, v19
    ds_write_b64 v182, v[8:9] offset:0
    ds_write_b64 v182, v[10:11] offset:16
    ds_write_b64 v183, v[12:13] offset:32
    v_mov_b32 v3, v32
    s_waitcnt lgkmcnt(0)
    ds_read_b128 v[104:107], v181
    v_permlane32_swap_b32 v32, v3
    v_rcp_f32 v178, v3
    s_nop 0
    v_pk_mul_f32 v[24:25], v[24:25], v[178:179] op_sel_hi:[1,0]
    v_pk_mul_f32 v[26:27], v[26:27], v[178:179] op_sel_hi:[1,0]
    v_pk_mul_f32 v[28:29], v[28:29], v[178:179] op_sel_hi:[1,0]
    v_pk_mul_f32 v[30:31], v[30:31], v[178:179] op_sel_hi:[1,0]
    v_pk_mul_f32 v[32:33], v[32:33], v[178:179] op_sel_hi:[1,0]
    v_pk_mul_f32 v[34:35], v[34:35], v[178:179] op_sel_hi:[1,0]
    v_cvt_pk_bf16_f32 v24, v24, v25
    v_cvt_pk_bf16_f32 v25, v26, v27
    v_cvt_pk_bf16_f32 v26, v28, v29
    v_cvt_pk_bf16_f32 v27, v30, v31
    v_cvt_pk_bf16_f32 v28, v32, v33
    v_cvt_pk_bf16_f32 v29, v34, v35
    ds_write_b64 v182, v[24:25] offset:3072
    ds_write_b64 v182, v[26:27] offset:3088
    ds_write_b64 v183, v[28:29] offset:3104
    s_waitcnt lgkmcnt(3)
    buffer_store_dwordx4 v[104:107], v173, s[24:27], s35 offen sc1
    s_waitcnt lgkmcnt(0)
    ds_read_b128 v[120:123], v181 offset:3072
    ds_read_b128 v[108:111], v184 offset:1024
    s_waitcnt lgkmcnt(1)
    buffer_store_dwordx4 v[120:123], v173, s[24:27], s35 offen offset:2560 sc1
    s_mov_b32 exec_hi, 0
    s_waitcnt lgkmcnt(0)
    buffer_store_dwordx4 v[108:111], v185, s[24:27], s35 offen offset:1024 sc1
    s_mov_b32 exec_hi, -1
    s_endpgm
.section .rodata,"a"
.p2align 6
.amdhsa_kernel standalone__fused_io_aware_attn__prompt_kernel
  .amdhsa_next_free_vgpr 240
  .amdhsa_next_free_sgpr 88
  .amdhsa_accum_offset 192
  .amdhsa_group_segment_fixed_size 0
  .amdhsa_kernarg_size 48
  .amdhsa_user_sgpr_count 2
  .amdhsa_user_sgpr_kernarg_segment_ptr 1
  .amdhsa_system_sgpr_workgroup_id_x 1
.end_amdhsa_kernel
```
